```python
import torch

def _softmax(x, axis=-1):
    return torch.softmax(x, dim=axis)
def _gelu(x):
    return torch.nn.functional.gelu(x, approximate="tanh")
def _silu(x):
    return torch.nn.functional.silu(x)
def _sigmoid(x):
    return torch.sigmoid(x)
def _layernorm(x, axis=-1, eps=1e-5):
    m = x.mean(dim=axis, keepdim=True)
    v = x.var(dim=axis, keepdim=True, unbiased=False)
    return (x - m) / torch.sqrt(v + eps)
def _scatter_add(tgt, idx, src, axis=0):
    return tgt.clone().index_add_(axis, idx, src)
def _segment_sum(src, seg, n):
    out = torch.zeros((n,) + src.shape[1:], dtype=src.dtype)
    return out.index_add_(0, seg, src)
def _pad(x, pw):
    flat = tuple(v for pair in reversed(pw) for v in pair)
    return torch.nn.functional.pad(x, flat)

kernel_name = 'recurrent_scan__sliding_block_cached__glu_gated_swiglu__decode'

def setup_inputs():

    _w = (lambda a: (lambda t: t.to(torch.bfloat16) if t.is_floating_point() else t)(torch.as_tensor(a)))
    def _A_setup():
        B, Sq, D = 4, 1, 512
        Hq, Hkv, Sk, Dh = 32, 8, 4096, 128
        assert Hq % Hkv == 0, (Hq, Hkv)
        return {
            "x": _w((lambda *s: torch.randn(*s, dtype=torch.bfloat16) * 0.05)(B, Sq, D)),
            "k_cache": _w((lambda *s: torch.randn(*s, dtype=torch.bfloat16) * 1.6)(B, Hkv, Sk, Dh)),
            "v_cache": _w((lambda *s: torch.randn(*s, dtype=torch.bfloat16) * 1.6)(B, Hkv, Sk, Dh)),
            "wq": _w((lambda *s: torch.randn(*s, dtype=torch.bfloat16) * 1.6)(D, Hq * Dh) * (D ** -0.5)),
            "wo": _w((lambda *s: torch.randn(*s, dtype=torch.bfloat16) * 1.6)(Hq * Dh, D) * ((Hq * Dh) ** -0.5)),
        }
    _A_in = _A_setup()

    def _B_setup():
        B, S, D, F = 4, 1, 512, 1792
        return {
            "x": _w((lambda *s: torch.randn(*s, dtype=torch.bfloat16) * 0.05)(B, S, D)),
            "w1": _w((lambda *s: torch.randn(*s, dtype=torch.bfloat16) * 0.2)(D, F) * (2.0 / D) ** 0.5),
            "w3": _w((lambda *s: torch.randn(*s, dtype=torch.bfloat16) * 0.2)(D, F) * (2.0 / D) ** 0.5),
            "w2": _w((lambda *s: torch.randn(*s, dtype=torch.bfloat16) * 0.2)(F, D) * (2.0 / F) ** 0.5),
        }
    _B_in = _B_setup()

    return {
        "A_x": _A_in["x"],
        "A_k_cache": _A_in["k_cache"],
        "A_v_cache": _A_in["v_cache"],
        "A_wq": _A_in["wq"],
        "A_wo": _A_in["wo"],
        "B_x": _B_in["x"],
        "B_w1": _B_in["w1"],
        "B_w3": _B_in["w3"],
        "B_w2": _B_in["w2"],
    }

def reference(A_x, A_k_cache, A_v_cache, A_wq, A_wo, B_x, B_w1, B_w3, B_w2):
    def _A_ref(x, k_cache, v_cache, wq, wo):
        B, Sq, D = x.shape
        Hq, Dh = 32, 128
        Hkv, Sk = k_cache.shape[1], k_cache.shape[2]
        W = min(4096, max(256, Sk // 4))
        rep = Hq // Hkv
        q = (lambda x, *d: x.permute(*d))((x @ wq).reshape(B, Sq, Hq, Dh), 0, 2, 1, 3)
        k = (lambda x, n, axis: torch.repeat_interleave(x, n, dim=axis))(k_cache[:, :, Sk - W:, :], rep, axis=1)
        v = (lambda x, n, axis: torch.repeat_interleave(x, n, dim=axis))(v_cache[:, :, Sk - W:, :], rep, axis=1)
        scores = torch.einsum("bhqd,bhkd->bhqk", q, k) * (Dh ** -0.5)
        p = _softmax(scores, axis=-1)
        o = torch.einsum("bhqk,bhkd->bhqd", p, v)
        return (lambda x, *d: x.permute(*d))(o, 0, 2, 1, 3).reshape(B, Sq, Hq * Dh) @ wo

    def _B_ref(x, w1, w3, w2):
        gate = torch.einsum("bsd,df->bsf", x, w1)
        up = torch.einsum("bsd,df->bsf", x, w3)
        h = _silu(gate) * up
        out = torch.einsum("bsf,fd->bsd", h, w2)
        return out

    x = A_x
    xn = _layernorm(x, axis=-1)
    s = _A_ref(xn, A_k_cache, A_v_cache, A_wq, A_wo)
    g = _silu(_B_ref(xn, B_w1, B_w3, B_w2))
    return x + s * g
```

```asm
; @launch grid=(256,1,1) block=(640,1,1) lds=137216
.amdgcn_target "amdgcn-amd-amdhsa--gfx950"
.text
.p2align 12
.fill 832, 4, 0xbf810000
.globl recurrent_scan__sliding_block_cached__glu_gated_swiglu__decode_kernel
.p2align 8
.type recurrent_scan__sliding_block_cached__glu_gated_swiglu__decode_kernel,@function
recurrent_scan__sliding_block_cached__glu_gated_swiglu__decode_kernel:
    v_lshrrev_b32 v1, 6, v0
    s_cmp_ge_u32 s2, 256
    v_readfirstlane_b32 s3, v1
    s_cbranch_scc1 L_end
    v_and_b32 v0, 63, v0
    v_mov_b32 v57, 0
    s_cmp_ge_u32 s3, 5
    s_cbranch_scc1 L_A0
    s_load_dwordx16 s[8:23], s[0:1], 0
    s_load_dwordx8 s[24:31], s[0:1], 64
    s_and_b32 s4, s2, 7
    s_lshr_b32 s5, s2, 3
    s_cmp_eq_u32 s3, 0
    s_cbranch_scc1 L_loader
    s_branch L_B
L_A0:
    s_cmp_lg_u32 s3, 9
    s_cbranch_scc1 L_A1
    v_lshlrev_b32 v1, 2, v0
    ds_write_b32 v1, v57 offset:62080
    ds_write_b32 v1, v57 offset:62336
    s_getpc_b64 s[6:7]
L_pc:
    v_lshlrev_b32 v2, 7, v0
    s_add_u32 s6, s6, recurrent_scan__sliding_block_cached__glu_gated_swiglu__decode_kernel + 1024 - L_pc
    s_addc_u32 s7, s7, 0
    v_mov_b32 v3, s7
    v_add_co_u32 v2, vcc, s6, v2
    s_nop 1
    v_addc_co_u32 v3, vcc, 0, v3, vcc
    global_load_dword v110, v[2:3], off
    s_nop 0
    v_add_co_u32 v2, vcc, 0x2000, v2
    s_nop 1
    v_addc_co_u32 v3, vcc, 0, v3, vcc
    v_cmp_gt_u32 vcc, (L_last - recurrent_scan__sliding_block_cached__glu_gated_swiglu__decode_kernel - 1024 - 0x2000 + 127) / 128, v0
    s_nop 0
    s_and_saveexec_b64 s[6:7], vcc
    global_load_dword v111, v[2:3], off
    s_mov_b64 exec, -1
L_A1:
    s_load_dwordx16 s[8:23], s[0:1], 0
    s_load_dwordx8 s[24:31], s[0:1], 64
    s_cmp_eq_u32 s3, 9
    s_cbranch_scc1 L_F
    s_branch L_A
L_loader:
    v_lshrrev_b32 v1, 3, v0
    v_and_b32 v2, 7, v0
    v_and_b32 v3, 2, v1
    v_xor_b32 v2, v2, v3
    v_lshlrev_b32 v2, 4, v2
    v_lshl_add_u32 v4, v1, 13, v2
    v_xor_b32 v5, 64, v4
    v_mul_u32_u24 v6, 3584, v1
    v_add_u32 v6, v6, v2
    v_xor_b32 v7, 64, v6
    v_lshl_add_u32 v8, v1, 10, v2
    v_xor_b32 v9, 64, v8
    v_lshrrev_b32 v1, 4, v0
    v_and_b32 v2, 15, v0
    v_xor_b32 v3, v2, v1
    v_lshlrev_b32 v3, 4, v3
    v_lshl_add_u32 v10, v1, 8, v3
    v_xor_b32 v11, 64, v10
    v_xor_b32 v12, 0x80, v10
    v_xor_b32 v13, 0xc0, v10
    v_lshlrev_b32 v3, 1, v1
    v_xor_b32 v3, v2, v3
    v_lshlrev_b32 v3, 4, v3
    v_lshl_add_u32 v14, v1, 8, v3
    v_xor_b32 v15, 0x80, v14
    v_lshlrev_b32 v3, 2, v1
    v_xor_b32 v3, v2, v3
    v_lshlrev_b32 v3, 4, v3
    v_lshl_add_u32 v20, v1, 8, v3
    v_xor_b32 v21, 16, v20
    v_xor_b32 v22, 32, v20
    v_xor_b32 v23, 48, v20
    v_lshlrev_b32 v24, 2, v0
    v_lshlrev_b32 v25, 4, v0
    v_add_u32 v16, 62208, v24
    s_lshr_b32 s43, s4, 1
    s_mul_i32 s43, s43, 7
    s_and_b32 s44, s4, 1
    s_lshr_b32 s6, s5, 3
    s_add_u32 s7, s6, s44
    s_lshr_b32 s100, s7, 2
    s_lshl_b32 s44, s44, 2
    s_add_u32 s43, s43, s44
    s_add_u32 s43, s43, s6
    s_and_b32 s44, s5, 7
    s_lshr_b32 s6, s44, 1
    s_mul_i32 s33, s6, 0x70000
    s_lshl_b32 s6, s43, 7
    s_add_u32 s33, s33, s6
    s_lshl_b32 s34, s43, 16
    s_lshl_b32 s6, s44, 7
    s_add_u32 s34, s34, s6
    s_cmp_lg_u32 s100, 0
    s_cselect_b32 s33, 0x7f000000, s33
    s_cselect_b32 s34, 0x7f000000, s34
    s_and_b32 s42, s44, 1
    s_lshr_b32 s6, s5, 3
    s_and_b32 s7, s5, 7
    s_lshl_b32 s32, s6, 20
    s_lshl_b32 s35, s4, 10
    s_add_u32 s32, s32, s35
    s_add_u32 s35, s7, 0
    s_and_b32 s35, s35, 7
    s_lshl_b32 s35, s35, 7
    s_add_u32 s32, s32, s35
    s_lshl_b32 s35, s7, 7
    s_lshl_b32 s37, s6, 3
    s_add_u32 s37, s37, s4
    s_lshl_b32 s37, s37, 20
    s_lshl_b32 s38, s7, 15
    s_add_u32 s37, s37, s38
    s_add_u32 s37, s37, 0xc0000
    s_mov_b32 s38, s37
    s_lshl_b32 s39, s4, 2
    s_add_u32 s39, s39, s6
    s_lshl_b32 s39, s39, 17
    s_add_u32 s39, s39, s35
    s_mov_b32 s46, 0x400000
    s_mov_b32 s47, 0x20000
    s_mov_b32 s50, 0x2000000
    s_mov_b32 s51, 0x20000
    s_mov_b32 s54, 0x2000000
    s_mov_b32 s55, 0x20000
    s_mov_b32 s58, 0x1c0000
    s_mov_b32 s59, 0x20000
    s_mov_b32 s62, 0x400000
    s_mov_b32 s63, 0x20000
    s_mov_b32 s66, 0x1c0000
    s_mov_b32 s67, 0x20000
    s_mov_b32 s40, 0x10000
    s_mov_b32 s41, 0x7000
    s_lshl_b32 s69, s4, 15
    s_lshl_b32 s6, s5, 10
    s_add_u32 s69, s69, s6
    s_add_u32 s69, s69, 0x10000
    s_lshl_b32 s68, s43, 13
    s_lshl_b32 s6, s44, 10
    s_add_u32 s68, s68, s6
    s_xor_b32 s101, s5, s4
    s_and_b32 s101, s101, 7
    s_lshl_b32 s101, s101, 12
    s_mov_b32 s90, 0x1e0000
    s_mov_b32 s91, 0x20000
    s_mov_b32 s98, 4096
    s_mov_b32 s99, 0x20000
    s_mov_b32 m0, 0x20000
    s_lshl_b32 s6, s5, 10
    s_and_b32 s6, s6, 0xc00
    s_waitcnt lgkmcnt(0)
    s_mov_b32 s96, s8
    s_mov_b32 s97, s9
    buffer_load_dwordx4 v20, s[96:99], 0 offen lds
    s_mov_b32 s88, s30
    s_mov_b32 s89, s31
    buffer_load_dwordx4 v21, s[96:99], 0 offen offset:1024 lds
    s_mov_b32 s44, s14
    s_mov_b32 s45, s15
    buffer_load_dwordx4 v22, s[96:99], 0 offen offset:2048 lds
    buffer_load_dwordx4 v23, s[96:99], 0 offen offset:3072 lds
    s_mov_b32 m0, 0x21000
    s_nop 0
    buffer_load_dword v24, s[88:91], 0 offen lds
    s_mov_b32 m0, 0
    s_nop 0
    buffer_load_dwordx4 v4, s[44:47], s32 offen nt lds
    s_addk_i32 m0, 1024
    s_add_u32 s32, s32, s40
    buffer_load_dwordx4 v5, s[44:47], s32 offen nt lds
    s_mov_b32 s48, s10
    s_mov_b32 s49, s11
    s_addk_i32 m0, 1024
    s_add_u32 s32, s32, s40
    buffer_load_dwordx4 v4, s[44:47], s32 offen nt lds
    s_mov_b32 s52, s12
    s_mov_b32 s53, s13
    s_addk_i32 m0, 1024
    s_add_u32 s32, s32, s40
    buffer_load_dwordx4 v5, s[44:47], s32 offen nt lds
    s_mov_b32 s60, s16
    s_mov_b32 s61, s17
    s_addk_i32 m0, 1024
    s_add_u32 s32, s32, s40
    buffer_load_dwordx4 v4, s[44:47], s32 offen nt lds
    s_mov_b32 s64, s24
    s_mov_b32 s65, s25
    s_addk_i32 m0, 1024
    s_add_u32 s32, s32, s40
    buffer_load_dwordx4 v5, s[44:47], s32 offen nt lds
    s_cmp_eq_u32 s42, 0
    s_cselect_b32 s56, s20, s22
    s_cselect_b32 s57, s21, s23
    s_addk_i32 m0, 1024
    s_add_u32 s32, s32, s40
    buffer_load_dwordx4 v4, s[44:47], s32 offen nt lds
    s_addk_i32 m0, 1024
    s_add_u32 s32, s32, s40
    buffer_load_dwordx4 v5, s[44:47], s32 offen nt lds
    s_addk_i32 m0, 1024
    s_add_u32 s32, s32, s40
    buffer_load_dwordx4 v4, s[44:47], s32 offen nt lds
    s_addk_i32 m0, 1024
    s_add_u32 s32, s32, s40
    buffer_load_dwordx4 v5, s[44:47], s32 offen nt lds
    s_addk_i32 m0, 1024
    s_add_u32 s32, s32, s40
    buffer_load_dwordx4 v4, s[44:47], s32 offen nt lds
    s_addk_i32 m0, 1024
    s_add_u32 s32, s32, s40
    buffer_load_dwordx4 v5, s[44:47], s32 offen nt lds
    s_addk_i32 m0, 1024
    s_add_u32 s32, s32, s40
    buffer_load_dwordx4 v4, s[44:47], s32 offen nt lds
    s_addk_i32 m0, 1024
    s_add_u32 s32, s32, s40
    buffer_load_dwordx4 v5, s[44:47], s32 offen nt lds
    s_addk_i32 m0, 1024
    s_add_u32 s32, s32, s40
    buffer_load_dwordx4 v4, s[44:47], s32 offen nt lds
    s_addk_i32 m0, 1024
    s_add_u32 s32, s32, s40
    buffer_load_dwordx4 v5, s[44:47], s32 offen nt lds
    s_barrier
    v_mov_b32 v17, 5
    s_waitcnt vmcnt(16)
    ds_write_b32 v16, v17
    v_mov_b32 v17, 1
    s_mov_b32 s43, s101
LsK1:
    s_add_u32 m0, s43, 0x10000
    s_add_u32 s7, s43, s37
    buffer_load_dwordx4 v10, s[48:51], s7 offen nt lds
    s_waitcnt vmcnt(20)
    buffer_load_dwordx4 v11, s[48:51], s7 offen offset:1024 nt lds
    s_waitcnt vmcnt(20)
    buffer_load_dwordx4 v12, s[48:51], s7 offen offset:2048 nt lds
    s_waitcnt vmcnt(20)
    buffer_load_dwordx4 v13, s[48:51], s7 offen offset:3072 nt lds
    s_waitcnt vmcnt(20)
    v_add_u32 v17, 4, v17
    ds_max_i32 v16, v17
    s_add_u32 s43, s43, 0x1000
    s_and_b32 s43, s43, 0x7000
    s_cmp_lg_u32 s43, s101
    s_cbranch_scc1 LsK1
    s_mov_b32 s43, s101
LsV2:
    s_add_u32 m0, s43, 0x18000
    s_add_u32 s7, s43, s38
    buffer_load_dwordx4 v14, s[52:55], s7 offen nt lds
    s_waitcnt vmcnt(20)
    buffer_load_dwordx4 v14, s[52:55], s7 offen offset:1024 nt lds
    s_waitcnt vmcnt(20)
    buffer_load_dwordx4 v15, s[52:55], s7 offen offset:2048 nt lds
    s_waitcnt vmcnt(20)
    buffer_load_dwordx4 v15, s[52:55], s7 offen offset:3072 nt lds
    s_waitcnt vmcnt(20)
    v_add_u32 v17, 4, v17
    ds_write_b32 v16, v17
    s_add_u32 s43, s43, 0x1000
    s_and_b32 s43, s43, 0x7000
    s_cmp_lg_u32 s43, s101
    s_cbranch_scc1 LsV2
    s_mov_b32 m0, 0x4000
Lsw133:
    s_nop 0
    buffer_load_dwordx4 v6, s[56:59], s33 offen nt lds
    s_addk_i32 m0, 1024
    s_add_u32 s33, s33, s41
    s_waitcnt vmcnt(20)
    buffer_load_dwordx4 v7, s[56:59], s33 offen nt lds
    s_addk_i32 m0, 1024
    s_add_u32 s33, s33, s41
    s_waitcnt vmcnt(20)
    v_add_u32 v17, 2, v17
    ds_write_b32 v16, v17
    s_cmp_lg_u32 m0, 0x8000
    s_cbranch_scc1 Lsw133
    s_mov_b32 m0, 0x8000
Lswo4:
    s_nop 0
    buffer_load_dwordx4 v8, s[60:63], s39 offen nt lds
    s_addk_i32 m0, 1024
    s_addk_i32 s39, 8192
    s_waitcnt vmcnt(20)
    buffer_load_dwordx4 v9, s[60:63], s39 offen nt lds
    s_addk_i32 m0, 1024
    s_addk_i32 s39, 8192
    s_waitcnt vmcnt(20)
    v_add_u32 v17, 2, v17
    ds_write_b32 v16, v17
    s_cmp_lg_u32 m0, 0xc000
    s_cbranch_scc1 Lswo4
    s_mov_b32 m0, 0xc000
Lsw25:
    s_nop 0
    buffer_load_dwordx4 v8, s[64:67], s34 offen nt lds
    s_addk_i32 m0, 1024
    s_addk_i32 s34, 8192
    s_waitcnt vmcnt(20)
    buffer_load_dwordx4 v9, s[64:67], s34 offen nt lds
    s_addk_i32 m0, 1024
    s_addk_i32 s34, 8192
    s_waitcnt vmcnt(20)
    v_add_u32 v17, 2, v17
    ds_write_b32 v16, v17
    s_cmp_lg_u32 m0, 0xe000
    s_cbranch_scc1 Lsw25
    s_waitcnt vmcnt(10)
    v_mov_b32 v17, 115
    ds_write_b32 v16, v17
    s_waitcnt vmcnt(9)
    v_mov_b32 v17, 116
    ds_write_b32 v16, v17
    s_waitcnt vmcnt(8)
    v_mov_b32 v17, 117
    ds_write_b32 v16, v17
    s_waitcnt vmcnt(6)
    v_mov_b32 v17, 119
    ds_write_b32 v16, v17
    s_waitcnt vmcnt(0)
    v_mov_b32 v17, 125
    ds_write_b32 v16, v17
    s_endpgm
L_F:
    s_and_b32 s4, s2, 7
    s_lshr_b32 s5, s2, 3
    s_lshl_b32 s6, s4, 3
    s_lshr_b32 s7, s5, 2
    s_add_u32 s6, s6, s7
    s_and_b32 s7, s5, 3
    s_lshl_b32 s43, s6, 12
    s_lshl_b32 s44, s7, 5
    s_add_u32 s43, s43, s44
    s_add_u32 s44, s43, 0x170000
    s_add_u32 s43, s43, 0x130000
    s_lshl_b32 s6, s6, 4
    s_lshl_b32 s7, s7, 2
    s_add_u32 s45, s6, s7
    v_lshrrev_b32 v1, 1, v0
    v_and_b32 v2, 1, v0
    v_lshlrev_b32 v18, 7, v1
    v_lshl_add_u32 v18, v2, 4, v18
    v_bfe_u32 v1, v0, 4, 1
    v_lshlrev_b32 v19, 11, v1
    v_lshl_add_u32 v19, v2, 1, v19
    s_lshr_b32 s6, s45, 4
    s_and_b32 s7, s6, 15
    s_lshr_b32 s6, s6, 4
    s_lshl_b32 s46, s6, 2
    s_xor_b32 s7, s7, s46
    s_lshl_b32 s7, s7, 4
    s_lshl_b32 s6, s6, 8
    s_add_u32 s6, s6, s7
    s_and_b32 s7, s45, 15
    s_add_u32 s6, s6, s7
    s_add_u32 s6, s6, 0x20000
    v_lshlrev_b32 v1, 5, v1
    v_xor_b32 v3, s6, v1
    v_add_u32 v3, v3, v19
    v_xor_b32 v2, 16, v3
    v_mov_b32 v4, 0x21000
    s_waitcnt lgkmcnt(0)
    s_barrier
Lwl6:
    ds_read_b32 v1, v57 offset:62208
    ds_read_u16 v20, v3
    ds_read_u16 v21, v2 offset:1024
    ds_read_b32 v22, v4
    s_waitcnt lgkmcnt(0)
    v_cmp_gt_i32 vcc, 5, v1
    s_cbranch_vccnz Lwl6
    s_mov_b32 s52, s26
    s_mov_b32 s53, s27
    s_mov_b32 s54, 0x1000
    s_mov_b32 s55, 0x20000
    s_mov_b32 s8, s30
    s_mov_b32 s9, s31
    s_mov_b32 s10, 0x1e0000
    s_mov_b32 s11, 0x20000
    v_readfirstlane_b32 s36, v22
    s_nop 0
    s_add_u32 s36, s36, 0x9e3779b9
    s_and_b32 s37, s36, 0xff
    s_bfe_u32 s38, s36, 0x80008
    s_bfe_u32 s39, s36, 0x80010
    s_lshr_b32 s40, s36, 24
    s_mov_b32 s41, 0xffffff00
    v_mov_b32 v60, s37
    v_mov_b32 v61, s38
    v_mov_b32 v62, s39
    v_mov_b32 v63, s40
    v_mov_b32 v28, v60
    v_mov_b32 v29, v61
    v_mov_b32 v30, v62
    v_mov_b32 v31, v63
    v_lshlrev_b32 v20, 16, v20
    v_lshlrev_b32 v21, 16, v21
    s_mov_b32 s46, -1
    s_mov_b32 s47, 0xffffff
Lwl7:
    ds_read_b32 v1, v57 offset:62208
    s_waitcnt lgkmcnt(0)
    v_cmp_gt_i32 vcc, 125, v1
    s_cbranch_vccnz Lwl7
Lwl8:
    ds_read_b32 v1, v57 offset:62104
    ds_read_b32 v2, v57 offset:62108
    s_waitcnt lgkmcnt(0)
    v_cmp_gt_i32 vcc, 8, v1
    s_cbranch_vccnz Lwl8
    v_cmp_ne_u32 vcc, 0, v2
    s_cbranch_vccz L_F_local
    buffer_wbl2 sc1
    s_waitcnt vmcnt(0)
L_F_local:
    s_mov_b32 s42, 20000
    s_mov_b64 s[48:49], -1
    s_mov_b64 s[50:51], s[46:47]
Lfg9:
    s_mov_b64 exec, s[48:49]
    s_cbranch_execz Lfg9a
    buffer_load_dwordx4 v[24:27], v18, s[8:11], s43 offen sc1
Lfg9a:
    s_mov_b64 exec, s[50:51]
    s_cbranch_execz Lfg9b
    buffer_load_dwordx4 v[28:31], v18, s[8:11], s44 offen sc1
Lfg9b:
    s_mov_b64 exec, -1
    s_waitcnt vmcnt(0)
    v_xor_b32 v32, s37, v24
    v_xor_b32 v33, s38, v25
    v_xor_b32 v34, s39, v26
    v_xor_b32 v35, s40, v27
    v_or3_b32 v1, v32, v33, v34
    v_or_b32 v1, v1, v35
    v_and_b32 v1, 0xff, v1
    v_cmp_ne_u32 s[48:49], 0, v1
    v_xor_b32 v36, s37, v28
    v_xor_b32 v37, s38, v29
    v_xor_b32 v38, s39, v30
    v_xor_b32 v39, s40, v31
    v_or3_b32 v1, v36, v37, v38
    v_or_b32 v1, v1, v39
    v_and_b32 v1, 0xff, v1
    v_cmp_ne_u32 s[50:51], 0, v1
    s_nop 0
    s_or_b64 vcc, s[48:49], s[50:51]
    s_cbranch_vccz Lfd10
    s_sub_u32 s42, s42, 1
    s_cmp_gt_u32 s42, 19936
    s_cbranch_scc1 Lfg9
    buffer_wbl2 sc1
    buffer_inv sc1
    s_waitcnt vmcnt(0)
    s_cmp_lg_u32 s42, 0
    s_cbranch_scc1 Lfg9
Lfd10:
    v_permlane32_swap_b32 v32, v36
    v_permlane32_swap_b32 v33, v37
    v_permlane32_swap_b32 v34, v38
    v_permlane32_swap_b32 v35, v39
    v_add_f32 v32, v32, v36
    v_add_f32 v33, v33, v37
    v_add_f32 v34, v34, v38
    v_add_f32 v35, v35, v39
    s_nop 0
    v_permlane16_swap_b32 v32, v34
    v_permlane16_swap_b32 v33, v35
    v_add_f32 v32, v32, v34
    v_add_f32 v33, v33, v35
    s_nop 0
    v_add_f32 v32, v32, v32 row_ror:8
    v_add_f32 v33, v33, v33 row_ror:8
    s_nop 0
    v_add_f32 v32, v32, v32 row_ror:4
    v_add_f32 v33, v33, v33 row_ror:4
    s_nop 0
    v_add_f32 v32, v32, v32 row_ror:2
    v_add_f32 v33, v33, v33 row_ror:2
    v_mov_b32 v34, v32
    v_mov_b32 v35, v33
    s_nop 0
    v_permlane32_swap_b32 v32, v34
    v_permlane32_swap_b32 v33, v35
    v_mul_f32 v36, 0xbfb8aa3b, v34
    v_mul_f32 v37, 0xbfb8aa3b, v35
    v_exp_f32 v36, v36
    v_exp_f32 v37, v37
    v_add_f32 v36, 1.0, v36
    v_add_f32 v37, 1.0, v37
    v_rcp_f32 v36, v36
    v_rcp_f32 v37, v37
    v_mul_f32 v32, v32, v34
    v_mul_f32 v33, v33, v35
    v_fma_f32 v20, v32, v36, v20
    v_fma_f32 v21, v33, v37, v21
    v_cvt_pk_bf16_f32 v21, v20, v21
    s_mov_b64 exec, 0x00030003
    buffer_store_short v21, v19, s[52:55], s45 offen
    buffer_store_short_d16_hi v21, v19, s[52:55], s45 offen offset:1024
    s_cmp_lg_u32 s2, 0
    s_cbranch_scc1 L_fin_done
    s_mov_b64 exec, 1
    v_mov_b32 v22, s36
    buffer_store_dword v22, v57, s[8:11], 0 offen
L_fin_done:
L_end:
    s_endpgm
.p2alignl 12, 0xbf810000
L_B:
    v_mov_b32 v59, 1
    s_sub_u32 s45, s3, 1
    v_and_b32 v1, 3, v0
    v_bfe_u32 v2, v0, 2, 2
    v_lshlrev_b32 v58, 10, v1
    v_lshl_add_u32 v58, v2, 8, v58
    v_lshrrev_b32 v3, 4, v0
    v_and_b32 v1, 15, v0
    v_xor_b32 v1, v1, v3
    v_lshl_add_u32 v58, v1, 4, v58
    v_add_u32 v58, 0x20000, v58
    v_xor_b32 v78, 64, v58
    v_xor_b32 v79, 0x80, v58
    v_xor_b32 v80, 0xc0, v58
    s_mov_b32 s34, 0x1e0000
    s_mov_b32 s35, 0x20000
    v_lshrrev_b32 v1, 4, v0
    v_bfe_u32 v2, v0, 2, 2
    v_lshl_add_u32 v3, v1, 3, v2
    v_lshlrev_b32 v56, 7, v3
    v_bfe_u32 v2, v0, 3, 1
    v_and_b32 v1, 1, v1
    v_lshl_or_b32 v2, v1, 1, v2
    v_xor_b32 v2, s45, v2
    v_lshl_add_u32 v56, v2, 5, v56
    v_and_b32 v1, 3, v0
    v_lshl_add_u32 v56, v1, 3, v56
    v_and_b32 v1, 3, v0
    v_lshrrev_b32 v3, 4, v0
    v_lshlrev_b32 v3, 4, v3
    v_lshl_add_u32 v64, v1, 13, v3
    v_lshl_add_u32 v65, v1, 11, v3
    v_bfe_u32 v66, v0, 3, 1
    v_lshlrev_b32 v66, 12, v66
    v_and_b32 v2, 7, v0
    v_lshl_add_u32 v66, v2, 4, v66
    v_mul_u32_u24 v67, 192, v1
    v_add_u32 v67, v67, v3
    v_lshlrev_b32 v68, 4, v0
    v_and_b32 v1, 15, v0
    v_lshrrev_b32 v3, 4, v0
    v_lshl_add_u32 v69, v1, 2, v3
    v_lshlrev_b32 v69, 1, v69
    s_mul_i32 s6, s45, 192
    v_add_u32 v69, s6, v69
    s_mov_b32 s46, 0x3f803f80
    s_mov_b32 s47, 0xffff0000
    s_lshr_b32 s43, s4, 1
    s_mul_i32 s43, s43, 7
    s_and_b32 s44, s4, 1
    s_lshr_b32 s6, s5, 3
    s_add_u32 s7, s6, s44
    s_lshr_b32 s100, s7, 2
    s_lshl_b32 s44, s44, 2
    s_add_u32 s43, s43, s44
    s_add_u32 s43, s43, s6
    s_and_b32 s44, s5, 7
    s_lshr_b32 s6, s5, 3
    s_lshl_b32 s7, s6, 2
    s_mov_b32 s52, 0x000f000f
    s_mov_b32 s53, 0x000f000f
    s_lshl_b64 s[54:55], s[52:53], s7
    s_lshl_b32 s48, s4, 15
    s_lshl_b32 s6, s6, 11
    s_add_u32 s48, s48, s6
    s_add_u32 s6, s5, 0
    s_and_b32 s6, s6, 7
    s_lshl_b32 s6, s6, 8
    s_add_u32 s48, s48, s6
    s_lshl_b32 s49, s45, 6
    s_add_u32 s48, s48, s49
    s_add_u32 s48, s48, 0x10000
    v_mov_b32 v81, 0x21000
    s_barrier
Lwl11:
    ds_read_b32 v1, v57 offset:62208
    ds_read_b32 v82, v81
    ds_read_b128 v[4:7], v58
    ds_read_b128 v[8:11], v78
    ds_read_b128 v[12:15], v79
    ds_read_b128 v[16:19], v80
    s_waitcnt lgkmcnt(0)
    v_cmp_gt_i32 vcc, 5, v1
    s_cbranch_vccnz Lwl11
    v_dot2_f32_bf16 v70, v4, s46, 0
    v_dot2_f32_bf16 v72, v4, v4, 0
    v_dot2_f32_bf16 v71, v5, s46, 0
    v_dot2_f32_bf16 v73, v5, v5, 0
    v_dot2_f32_bf16 v70, v6, s46, v70
    v_dot2_f32_bf16 v72, v6, v6, v72
    v_dot2_f32_bf16 v71, v7, s46, v71
    v_dot2_f32_bf16 v73, v7, v7, v73
    v_dot2_f32_bf16 v70, v8, s46, v70
    v_dot2_f32_bf16 v72, v8, v8, v72
    v_dot2_f32_bf16 v71, v9, s46, v71
    v_dot2_f32_bf16 v73, v9, v9, v73
    v_dot2_f32_bf16 v70, v10, s46, v70
    v_dot2_f32_bf16 v72, v10, v10, v72
    v_dot2_f32_bf16 v71, v11, s46, v71
    v_dot2_f32_bf16 v73, v11, v11, v73
    v_dot2_f32_bf16 v70, v12, s46, v70
    v_dot2_f32_bf16 v72, v12, v12, v72
    v_dot2_f32_bf16 v71, v13, s46, v71
    v_dot2_f32_bf16 v73, v13, v13, v73
    v_dot2_f32_bf16 v70, v14, s46, v70
    v_dot2_f32_bf16 v72, v14, v14, v72
    v_dot2_f32_bf16 v71, v15, s46, v71
    v_dot2_f32_bf16 v73, v15, v15, v73
    v_dot2_f32_bf16 v70, v16, s46, v70
    v_dot2_f32_bf16 v72, v16, v16, v72
    v_dot2_f32_bf16 v71, v17, s46, v71
    v_dot2_f32_bf16 v73, v17, v17, v73
    v_dot2_f32_bf16 v70, v18, s46, v70
    v_dot2_f32_bf16 v72, v18, v18, v72
    v_dot2_f32_bf16 v71, v19, s46, v71
    v_dot2_f32_bf16 v73, v19, v19, v73
    s_nop 1
    v_add_f32 v70, v70, v71
    v_add_f32 v72, v72, v73
    s_nop 1
    v_permlane32_swap_b32 v70, v72
    v_add_f32 v70, v70, v72
    v_mov_b32 v72, v70
    s_nop 1
    v_permlane16_swap_b32 v70, v72
    v_add_f32 v70, v70, v72
    s_nop 1
    v_add_f32 v70, v70, v70 row_ror:4
    s_nop 1
    v_add_f32 v70, v70, v70 row_ror:8
    v_mul_f32 v70, 0x3b000000, v70
    v_mov_b32 v72, v70
    s_nop 1
    v_permlane32_swap_b32 v70, v72
    v_fma_f32 v72, -v70, v70, v72
    v_max_f32 v72, 0, v72
    v_cvt_pk_bf16_f32 v72, v72, v72
    v_lshlrev_b32 v72, 16, v72
    v_add_f32 v72, 0x3727c5ac, v72
    v_cvt_pk_bf16_f32 v72, v72, v72
    v_lshlrev_b32 v72, 16, v72
    v_sqrt_f32 v72, v72
    v_cvt_pk_bf16_f32 v70, v70, v70
    v_lshlrev_b32 v70, 16, v70
    v_cvt_pk_bf16_f32 v72, v72, v72
    v_lshlrev_b32 v72, 16, v72
    v_rcp_f32 v72, v72
    v_sub_f32 v70, 0, v70
    v_lshlrev_b32 v74, 16, v4
    v_and_b32 v75, s47, v4
    v_lshlrev_b32 v76, 16, v5
    v_and_b32 v77, s47, v5
    v_pk_add_f32 v[74:75], v[74:75], v[70:71] op_sel_hi:[1,0]
    v_pk_add_f32 v[76:77], v[76:77], v[70:71] op_sel_hi:[1,0]
    v_cvt_pk_bf16_f32 v75, v74, v75
    v_cvt_pk_bf16_f32 v77, v76, v77
    v_lshlrev_b32 v74, 16, v75
    v_lshlrev_b32 v76, 16, v77
    v_and_b32 v75, s47, v75
    v_and_b32 v77, s47, v77
    v_pk_mul_f32 v[74:75], v[74:75], v[72:73] op_sel_hi:[1,0]
    v_pk_mul_f32 v[76:77], v[76:77], v[72:73] op_sel_hi:[1,0]
    v_cvt_pk_bf16_f32 v20, v74, v75
    v_cvt_pk_bf16_f32 v21, v76, v77
    v_lshlrev_b32 v74, 16, v6
    v_and_b32 v75, s47, v6
    v_lshlrev_b32 v76, 16, v7
    v_and_b32 v77, s47, v7
    v_pk_add_f32 v[74:75], v[74:75], v[70:71] op_sel_hi:[1,0]
    v_pk_add_f32 v[76:77], v[76:77], v[70:71] op_sel_hi:[1,0]
    v_cvt_pk_bf16_f32 v75, v74, v75
    v_cvt_pk_bf16_f32 v77, v76, v77
    v_lshlrev_b32 v74, 16, v75
    v_lshlrev_b32 v76, 16, v77
    v_and_b32 v75, s47, v75
    v_and_b32 v77, s47, v77
    v_pk_mul_f32 v[74:75], v[74:75], v[72:73] op_sel_hi:[1,0]
    v_pk_mul_f32 v[76:77], v[76:77], v[72:73] op_sel_hi:[1,0]
    v_cvt_pk_bf16_f32 v22, v74, v75
    v_cvt_pk_bf16_f32 v23, v76, v77
    v_lshlrev_b32 v74, 16, v8
    v_and_b32 v75, s47, v8
    v_lshlrev_b32 v76, 16, v9
    v_and_b32 v77, s47, v9
    v_pk_add_f32 v[74:75], v[74:75], v[70:71] op_sel_hi:[1,0]
    v_pk_add_f32 v[76:77], v[76:77], v[70:71] op_sel_hi:[1,0]
    v_cvt_pk_bf16_f32 v75, v74, v75
    v_cvt_pk_bf16_f32 v77, v76, v77
    v_lshlrev_b32 v74, 16, v75
    v_lshlrev_b32 v76, 16, v77
    v_and_b32 v75, s47, v75
    v_and_b32 v77, s47, v77
    v_pk_mul_f32 v[74:75], v[74:75], v[72:73] op_sel_hi:[1,0]
    v_pk_mul_f32 v[76:77], v[76:77], v[72:73] op_sel_hi:[1,0]
    v_cvt_pk_bf16_f32 v24, v74, v75
    v_cvt_pk_bf16_f32 v25, v76, v77
    v_lshlrev_b32 v74, 16, v10
    v_and_b32 v75, s47, v10
    v_lshlrev_b32 v76, 16, v11
    v_and_b32 v77, s47, v11
    v_pk_add_f32 v[74:75], v[74:75], v[70:71] op_sel_hi:[1,0]
    v_pk_add_f32 v[76:77], v[76:77], v[70:71] op_sel_hi:[1,0]
    v_cvt_pk_bf16_f32 v75, v74, v75
    v_cvt_pk_bf16_f32 v77, v76, v77
    v_lshlrev_b32 v74, 16, v75
    v_lshlrev_b32 v76, 16, v77
    v_and_b32 v75, s47, v75
    v_and_b32 v77, s47, v77
    v_pk_mul_f32 v[74:75], v[74:75], v[72:73] op_sel_hi:[1,0]
    v_pk_mul_f32 v[76:77], v[76:77], v[72:73] op_sel_hi:[1,0]
    v_cvt_pk_bf16_f32 v26, v74, v75
    v_cvt_pk_bf16_f32 v27, v76, v77
    v_lshlrev_b32 v74, 16, v12
    v_and_b32 v75, s47, v12
    v_lshlrev_b32 v76, 16, v13
    v_and_b32 v77, s47, v13
    v_pk_add_f32 v[74:75], v[74:75], v[70:71] op_sel_hi:[1,0]
    v_pk_add_f32 v[76:77], v[76:77], v[70:71] op_sel_hi:[1,0]
    v_cvt_pk_bf16_f32 v75, v74, v75
    v_cvt_pk_bf16_f32 v77, v76, v77
    v_lshlrev_b32 v74, 16, v75
    v_lshlrev_b32 v76, 16, v77
    v_and_b32 v75, s47, v75
    v_and_b32 v77, s47, v77
    v_pk_mul_f32 v[74:75], v[74:75], v[72:73] op_sel_hi:[1,0]
    v_pk_mul_f32 v[76:77], v[76:77], v[72:73] op_sel_hi:[1,0]
    v_cvt_pk_bf16_f32 v28, v74, v75
    v_cvt_pk_bf16_f32 v29, v76, v77
    v_lshlrev_b32 v74, 16, v14
    v_and_b32 v75, s47, v14
    v_lshlrev_b32 v76, 16, v15
    v_and_b32 v77, s47, v15
    v_pk_add_f32 v[74:75], v[74:75], v[70:71] op_sel_hi:[1,0]
    v_pk_add_f32 v[76:77], v[76:77], v[70:71] op_sel_hi:[1,0]
    v_cvt_pk_bf16_f32 v75, v74, v75
    v_cvt_pk_bf16_f32 v77, v76, v77
    v_lshlrev_b32 v74, 16, v75
    v_lshlrev_b32 v76, 16, v77
    v_and_b32 v75, s47, v75
    v_and_b32 v77, s47, v77
    v_pk_mul_f32 v[74:75], v[74:75], v[72:73] op_sel_hi:[1,0]
    v_pk_mul_f32 v[76:77], v[76:77], v[72:73] op_sel_hi:[1,0]
    v_cvt_pk_bf16_f32 v30, v74, v75
    v_cvt_pk_bf16_f32 v31, v76, v77
    v_lshlrev_b32 v74, 16, v16
    v_and_b32 v75, s47, v16
    v_lshlrev_b32 v76, 16, v17
    v_and_b32 v77, s47, v17
    v_pk_add_f32 v[74:75], v[74:75], v[70:71] op_sel_hi:[1,0]
    v_pk_add_f32 v[76:77], v[76:77], v[70:71] op_sel_hi:[1,0]
    v_cvt_pk_bf16_f32 v75, v74, v75
    v_cvt_pk_bf16_f32 v77, v76, v77
    v_lshlrev_b32 v74, 16, v75
    v_lshlrev_b32 v76, 16, v77
    v_and_b32 v75, s47, v75
    v_and_b32 v77, s47, v77
    v_pk_mul_f32 v[74:75], v[74:75], v[72:73] op_sel_hi:[1,0]
    v_pk_mul_f32 v[76:77], v[76:77], v[72:73] op_sel_hi:[1,0]
    v_cvt_pk_bf16_f32 v32, v74, v75
    v_cvt_pk_bf16_f32 v33, v76, v77
    v_lshlrev_b32 v74, 16, v18
    v_and_b32 v75, s47, v18
    v_lshlrev_b32 v76, 16, v19
    v_and_b32 v77, s47, v19
    v_pk_add_f32 v[74:75], v[74:75], v[70:71] op_sel_hi:[1,0]
    v_pk_add_f32 v[76:77], v[76:77], v[70:71] op_sel_hi:[1,0]
    v_cvt_pk_bf16_f32 v75, v74, v75
    v_cvt_pk_bf16_f32 v77, v76, v77
    v_lshlrev_b32 v74, 16, v75
    v_lshlrev_b32 v76, 16, v77
    v_and_b32 v75, s47, v75
    v_and_b32 v77, s47, v77
    v_pk_mul_f32 v[74:75], v[74:75], v[72:73] op_sel_hi:[1,0]
    v_pk_mul_f32 v[76:77], v[76:77], v[72:73] op_sel_hi:[1,0]
    v_cvt_pk_bf16_f32 v34, v74, v75
    v_cvt_pk_bf16_f32 v35, v76, v77
    v_readfirstlane_b32 s36, v82
    s_mov_b32 s32, s30
    s_mov_b32 s33, s31
    s_add_u32 s36, s36, 0x9e3779b9
    s_and_b32 s37, s36, 0xff
    s_bfe_u32 s38, s36, 0x80008
    s_bfe_u32 s39, s36, 0x80010
    s_lshr_b32 s40, s36, 24
    s_mov_b32 s41, 0xffffff00
    v_mov_b32 v60, s37
    v_mov_b32 v61, s38
    v_mov_b32 v62, s39
    v_mov_b32 v63, s40
    s_getreg_b32 s57, hwreg(HW_REG_XCC_ID, 0, 4)
    s_xor_b32 s57, s57, s40
    v_mov_b32 v83, s57
Lwl12:
    ds_read_b32 v1, v57 offset:62208
    s_waitcnt lgkmcnt(0)
    v_cmp_gt_i32 vcc, 17, v1
    s_cbranch_vccnz Lwl12
Lwl13:
    ds_read_b32 v1, v57 offset:62208
    ds_read_b64_tr_b16 v[40:41], v56 offset:0
    ds_read_b64_tr_b16 v[42:43], v56 offset:512
    ds_read_b64_tr_b16 v[44:45], v56 offset:4096
    ds_read_b64_tr_b16 v[46:47], v56 offset:4608
    ds_read_b64_tr_b16 v[48:49], v56 offset:8192
    ds_read_b64_tr_b16 v[50:51], v56 offset:8704
    ds_read_b64_tr_b16 v[52:53], v56 offset:12288
    ds_read_b64_tr_b16 v[54:55], v56 offset:12800
    s_waitcnt lgkmcnt(0)
    v_cmp_gt_i32 vcc, 21, v1
    s_cbranch_vccnz Lwl13
    v_mfma_f32_16x16x32_bf16 v[36:39], v[40:43], v[20:23], 0
    v_mfma_f32_16x16x32_bf16 v[36:39], v[44:47], v[24:27], v[36:39]
    v_mfma_f32_16x16x32_bf16 v[36:39], v[48:51], v[28:31], v[36:39]
    v_mfma_f32_16x16x32_bf16 v[36:39], v[52:55], v[32:35], v[36:39]
    s_nop 7
    v_and_or_b32 v36, v36, s41, v60
    v_and_or_b32 v37, v37, s41, v61
    v_and_or_b32 v38, v38, s41, v62
    v_and_or_b32 v39, v39, s41, v83
    s_mov_b64 exec, s[54:55]
    buffer_store_dwordx4 v[36:39], v64, s[32:35], s48 offen
    s_mov_b64 exec, -1
    s_cmp_lg_u32 s100, 0
    s_cbranch_scc1 L_B_done
    s_lshr_b32 s6, s44, 1
    s_lshl_b32 s7, s6, 2
    s_lshl_b64 s[54:55], s[52:53], s7
    s_lshl_b32 s50, s43, 13
    s_add_u32 s50, s50, 0x60000
    s_lshl_b32 s6, s6, 8
    s_add_u32 s48, s50, s6
    s_and_b32 s6, s44, 1
    s_lshl_b32 s6, s6, 10
    s_add_u32 s48, s48, s6
    s_add_u32 s48, s48, s49
    s_lshl_b32 s6, s45, 11
    s_add_u32 s50, s50, s6
    s_lshl_b32 s51, s44, 2
    s_add_u32 s51, s51, s45
    s_lshl_b32 s51, s51, 13
    s_lshl_b32 s6, s43, 7
    s_add_u32 s51, s51, s6
    s_add_u32 s51, s51, 0x170000
Lwl14:
    ds_read_b32 v1, v57 offset:62208
    s_waitcnt lgkmcnt(0)
    v_cmp_gt_i32 vcc, 99, v1
    s_cbranch_vccnz Lwl14
Lwl15:
    ds_read_b32 v1, v57 offset:62208
    ds_read_b64_tr_b16 v[40:41], v56 offset:16384
    ds_read_b64_tr_b16 v[42:43], v56 offset:16896
    ds_read_b64_tr_b16 v[44:45], v56 offset:20480
    ds_read_b64_tr_b16 v[46:47], v56 offset:20992
    ds_read_b64_tr_b16 v[48:49], v56 offset:24576
    ds_read_b64_tr_b16 v[50:51], v56 offset:25088
    ds_read_b64_tr_b16 v[52:53], v56 offset:28672
    ds_read_b64_tr_b16 v[54:55], v56 offset:29184
    s_waitcnt lgkmcnt(0)
    v_cmp_gt_i32 vcc, 101, v1
    s_cbranch_vccnz Lwl15
    v_mfma_f32_16x16x32_bf16 v[36:39], v[40:43], v[20:23], 0
    v_mfma_f32_16x16x32_bf16 v[36:39], v[44:47], v[24:27], v[36:39]
    v_mfma_f32_16x16x32_bf16 v[36:39], v[48:51], v[28:31], v[36:39]
    v_mfma_f32_16x16x32_bf16 v[36:39], v[52:55], v[32:35], v[36:39]
    s_nop 7
    v_and_or_b32 v36, v36, s41, v60
    v_and_or_b32 v37, v37, s41, v61
    v_and_or_b32 v38, v38, s41, v62
    v_and_or_b32 v39, v39, s41, v63
    s_mov_b64 exec, s[54:55]
    buffer_store_dwordx4 v[36:39], v65, s[32:35], s48 offen
    s_mov_b64 exec, -1
Lwl16:
    ds_read_b32 v1, v57 offset:62208
    s_waitcnt lgkmcnt(0)
    v_cmp_gt_i32 vcc, 119, v1
    s_cbranch_vccnz Lwl16
    s_mov_b32 s42, 20000
    buffer_load_dwordx4 v[4:7], v68, s[32:35], s50 offen sc1
    buffer_load_dwordx4 v[8:11], v68, s[32:35], s50 offen offset:1024 sc1
    s_branch Lhc19
Lhg17:
    buffer_load_dwordx4 v[4:7], v68, s[32:35], s50 offen sc1
    buffer_load_dwordx4 v[8:11], v68, s[32:35], s50 offen offset:1024 sc1
Lhc19:
    s_waitcnt vmcnt(1)
    v_xor_b32 v12, s37, v4
    v_xor_b32 v13, s38, v5
    v_xor_b32 v14, s39, v6
    v_xor_b32 v15, s40, v7
    v_or3_b32 v1, v12, v13, v14
    v_or_b32 v1, v1, v15
    s_waitcnt vmcnt(0)
    v_xor_b32 v16, s37, v8
    v_xor_b32 v17, s38, v9
    v_xor_b32 v18, s39, v10
    v_xor_b32 v19, s40, v11
    v_or3_b32 v1, v1, v16, v17
    v_or3_b32 v1, v1, v18, v19
    v_and_b32 v1, 0xff, v1
    v_cmp_ne_u32 vcc, 0, v1
    s_cbranch_vccz Lhd18
    s_sub_u32 s42, s42, 1
    s_cmp_gt_u32 s42, 19936
    s_cbranch_scc1 Lhg17
    buffer_wbl2 sc1
    buffer_inv sc1
    s_waitcnt vmcnt(0)
    s_cmp_lg_u32 s42, 0
    s_cbranch_scc1 Lhg17
Lhd18:
    v_permlane32_swap_b32 v12, v14
    v_permlane32_swap_b32 v13, v15
    v_permlane32_swap_b32 v16, v18
    v_permlane32_swap_b32 v17, v19
    v_add_f32 v12, v12, v14
    v_add_f32 v13, v13, v15
    v_add_f32 v16, v16, v18
    v_add_f32 v17, v17, v19
    v_permlane16_swap_b32 v12, v13
    s_nop 0
    v_permlane16_swap_b32 v16, v17
    v_add_f32 v12, v12, v13
    v_add_f32 v16, v16, v17
    v_cvt_pk_bf16_f32 v12, v12, v16
    v_and_b32 v16, s47, v12
    v_lshlrev_b32 v12, 16, v12
    v_mul_f32 v13, 0xbfb8aa3b, v12
    v_exp_f32 v13, v13
    s_nop 0
    v_add_f32 v13, 1.0, v13
    v_rcp_f32 v13, v13
    s_nop 0
    v_mul_f32 v12, v12, v13
    v_cvt_pk_bf16_f32 v12, v12, v12
    v_lshlrev_b32 v12, 16, v12
    v_mul_f32 v12, v12, v16
    v_cvt_pk_bf16_f32 v12, v12, v12
    ds_write_b16 v69, v12 offset:61184
    s_mov_b64 exec, 1
    ds_add_u32 v57, v59 offset:62096
    s_mov_b64 exec, -1
Lwl20:
    ds_read_b32 v1, v57 offset:62208
    ds_read_b64_tr_b16 v[40:41], v56 offset:49152
    ds_read_b64_tr_b16 v[42:43], v56 offset:49664
    ds_read_b64_tr_b16 v[44:45], v56 offset:53248
    ds_read_b64_tr_b16 v[46:47], v56 offset:53760
    s_waitcnt lgkmcnt(0)
    v_cmp_gt_i32 vcc, 125, v1
    s_cbranch_vccnz Lwl20
Lwl21:
    ds_read_b32 v1, v57 offset:62096
    ds_read_b128 v[20:23], v67 offset:61184
    ds_read_b128 v[24:27], v67 offset:61248
    s_waitcnt lgkmcnt(0)
    v_cmp_gt_i32 vcc, 4, v1
    s_cbranch_vccnz Lwl21
    v_mfma_f32_16x16x32_bf16 v[36:39], v[20:23], v[40:43], 0
    v_mfma_f32_16x16x32_bf16 v[36:39], v[24:27], v[44:47], v[36:39]
    s_nop 7
    v_and_or_b32 v36, v36, s41, v60
    v_and_or_b32 v37, v37, s41, v61
    v_and_or_b32 v38, v38, s41, v62
    v_and_or_b32 v39, v39, s41, v63
    s_mov_b64 exec, 0xffff
    buffer_store_dwordx4 v[36:39], v66, s[32:35], s51 offen sc1
L_B_done:
    s_waitcnt vmcnt(0)
    s_mov_b64 exec, 1
    ds_add_u32 v57, v59 offset:62104
    s_mov_b64 exec, -1
    s_endpgm
.p2alignl 12, 0xbf810000
L_A:
    v_mov_b32 v59, 1
    s_and_b32 s4, s2, 7
    s_lshr_b32 s5, s2, 3
    s_sub_u32 s45, s3, 5
    v_lshrrev_b32 v1, 4, v0
    v_bfe_u32 v2, v0, 2, 2
    v_lshl_add_u32 v3, v1, 3, v2
    v_lshlrev_b32 v56, 7, v3
    v_bfe_u32 v2, v0, 3, 1
    v_and_b32 v1, 1, v1
    v_lshl_or_b32 v2, v1, 1, v2
    v_xor_b32 v2, s45, v2
    v_lshl_add_u32 v56, v2, 5, v56
    v_and_b32 v1, 3, v0
    v_lshl_add_u32 v56, v1, 3, v56
    v_and_b32 v1, 31, v0
    v_lshrrev_b32 v2, 5, v0
    v_lshlrev_b32 v40, 4, v1
    v_lshl_add_u32 v40, v2, 12, v40
    v_lshlrev_b32 v41, 3, v1
    v_lshl_add_u32 v41, v2, 2, v41
    s_mul_i32 s6, s45, 320
    v_add_u32 v41, s6, v41
    v_and_b32 v1, 3, v0
    v_lshrrev_b32 v2, 4, v0
    v_lshlrev_b32 v3, 4, v2
    v_mul_u32_u24 v42, 320, v1
    v_lshl_add_u32 v43, v2, 3, v42
    s_lshl_b32 s7, s45, 6
    v_add_u32 v43, s7, v43
    v_add_u32 v42, v42, v3
    v_lshl_add_u32 v44, v1, 14, v3
    v_lshlrev_b32 v46, 4, v1
    s_lshl_b32 s7, s45, 2
    v_add_u32 v47, s7, v46
    v_and_b32 v1, 15, v0
    v_xor_b32 v3, v2, v1
    v_lshlrev_b32 v3, 4, v3
    v_lshl_add_u32 v48, v1, 8, v3
    s_lshl_b32 s7, s45, 13
    s_add_u32 s7, s7, 0x10000
    v_add_u32 v48, s7, v48
    v_xor_b32 v49, 64, v48
    v_xor_b32 v50, 0x80, v48
    v_xor_b32 v51, 0xc0, v48
    v_bfe_u32 v1, v0, 2, 2
    v_lshl_add_u32 v3, v2, 3, v1
    v_lshlrev_b32 v52, 8, v3
    v_and_b32 v2, 1, v2
    v_lshl_or_b32 v1, v2, 2, v1
    s_lshl_b32 s7, s45, 1
    v_xor_b32 v1, s7, v1
    v_lshl_add_u32 v52, v1, 5, v52
    v_and_b32 v1, 3, v0
    v_lshl_add_u32 v52, v1, 3, v52
    v_add_u32 v52, 0x18000, v52
    v_xor_b32 v53, 32, v52
    v_lshrrev_b32 v1, 3, v0
    v_and_b32 v2, 7, v0
    v_and_b32 v45, 1, v1
    v_lshlrev_b32 v45, 12, v45
    v_lshl_add_u32 v45, v2, 4, v45
    v_lshlrev_b32 v54, 7, v1
    v_lshlrev_b32 v55, 9, v1
    v_lshl_add_u32 v55, v2, 4, v55
    v_lshrrev_b32 v1, 4, v0
    v_lshlrev_b32 v1, 6, v1
    v_lshl_add_u32 v58, v2, 3, v1
    v_add_u32 v58, s6, v58
    s_mov_b32 s34, 0x1e0000
    s_mov_b32 s35, 0x20000
    s_lshr_b32 s6, s5, 3
    s_and_b32 s7, s5, 7
    s_lshl_b32 s46, s4, 2
    s_add_u32 s46, s46, s6
    s_lshl_b32 s47, s46, 13
    s_lshl_b32 s48, s45, 9
    s_add_u32 s47, s47, s48
    s_add_u32 s47, s47, 0x10000
    s_lshl_b32 s48, s4, 2
    s_add_u32 s48, s48, s45
    s_lshl_b32 s48, s48, 2
    s_add_u32 s48, s48, s6
    s_lshl_b32 s48, s48, 10
    s_lshl_b32 s49, s7, 7
    s_add_u32 s48, s48, s49
    s_add_u32 s48, s48, 0x1c0000
    s_lshl_b32 s49, s4, 4
    s_add_u32 s49, s49, s6
    s_lshl_b32 s49, s49, 12
    s_lshl_b32 s50, s7, 9
    s_add_u32 s49, s49, s50
    s_lshl_b32 s50, s45, 7
    s_add_u32 s49, s49, s50
    s_add_u32 s49, s49, 0xb0000
    s_lshl_b32 s50, s46, 2
    s_add_u32 s50, s50, s45
    s_lshl_b32 s51, s50, 12
    s_add_u32 s51, s51, 0xb0000
    s_lshl_b32 s50, s50, 10
    s_add_u32 s50, s50, 0x1c0000
    s_lshl_b32 s54, s7, 2
    s_add_u32 s54, s54, s45
    s_lshl_b32 s54, s54, 13
    s_lshl_b32 s55, s46, 7
    s_add_u32 s54, s54, s55
    s_add_u32 s54, s54, 0x130000
    s_mov_b32 s52, 0x000f000f
    s_mov_b32 s53, 0x000f000f
    s_mov_b32 s56, 0x3e0293ee
    s_lshl_b64 s[58:59], 1, s45
    v_mov_b32 v4, 0x21000
    s_barrier
Lwl22:
    ds_read_b32 v1, v57 offset:62208
    ds_read_b32 v5, v4
    s_waitcnt lgkmcnt(0)
    v_cmp_gt_i32 vcc, 5, v1
    s_cbranch_vccnz Lwl22
    v_readfirstlane_b32 s36, v5
    s_mov_b32 s32, s30
    s_mov_b32 s33, s31
    s_add_u32 s36, s36, 0x9e3779b9
    s_and_b32 s37, s36, 0xff
    s_bfe_u32 s38, s36, 0x80008
    s_bfe_u32 s39, s36, 0x80010
    s_lshr_b32 s40, s36, 24
    s_mov_b32 s41, 0xffffff00
    v_mov_b32 v60, s37
    v_mov_b32 v61, s38
    v_mov_b32 v62, s39
    v_mov_b32 v63, s40
    s_getreg_b32 s57, hwreg(HW_REG_XCC_ID, 0, 4)
    s_xor_b32 s57, s57, s40
Lwl23:
    ds_read_b32 v1, v57 offset:62208
    s_waitcnt lgkmcnt(0)
    v_cmp_gt_i32 vcc, 37, v1
    s_cbranch_vccnz Lwl23
    s_mov_b32 s42, 20000
    buffer_load_dwordx4 v[4:7], v40, s[32:35], s47 offen sc1
    buffer_load_dwordx4 v[8:11], v40, s[32:35], s47 offen offset:2048 sc1
Lwl26:
    ds_read_b32 v1, v57 offset:62208
    s_waitcnt lgkmcnt(0)
    v_cmp_gt_i32 vcc, 49, v1
    s_cbranch_vccnz Lwl26
Lwl27:
    ds_read_b32 v1, v57 offset:62208
    ds_read_b128 v[64:67], v48
    ds_read_b128 v[68:71], v49
    ds_read_b128 v[72:75], v50
    ds_read_b128 v[76:79], v51
    ds_read_b128 v[80:83], v48 offset:4096
    ds_read_b128 v[84:87], v49 offset:4096
    ds_read_b128 v[88:91], v50 offset:4096
    ds_read_b128 v[92:95], v51 offset:4096
    s_waitcnt lgkmcnt(0)
    v_cmp_gt_i32 vcc, 53, v1
    s_cbranch_vccnz Lwl27
    s_waitcnt vmcnt(1)
    v_xor_b32 v12, s37, v4
    v_xor_b32 v13, s38, v5
    v_xor_b32 v14, s39, v6
    v_xor_b32 v15, s57, v7
    v_or3_b32 v1, v12, v13, v14
    v_or_b32 v1, v1, v15
    s_waitcnt vmcnt(0)
    v_xor_b32 v16, s37, v8
    v_xor_b32 v17, s38, v9
    v_xor_b32 v18, s39, v10
    v_xor_b32 v19, s57, v11
    v_or3_b32 v1, v1, v16, v17
    v_or3_b32 v1, v1, v18, v19
    v_and_b32 v1, 0xff, v1
    v_cmp_ne_u32 vcc, 0, v1
    s_cbranch_vccz Lqd25
Lqg24:
    buffer_load_dwordx4 v[4:7], v40, s[32:35], s47 offen sc1
    buffer_load_dwordx4 v[8:11], v40, s[32:35], s47 offen offset:2048 sc1
    s_waitcnt vmcnt(1)
    v_xor_b32 v12, s37, v4
    v_xor_b32 v13, s38, v5
    v_xor_b32 v14, s39, v6
    v_xor_b32 v15, s57, v7
    v_or3_b32 v1, v12, v13, v14
    v_or_b32 v1, v1, v15
    s_waitcnt vmcnt(0)
    v_xor_b32 v16, s37, v8
    v_xor_b32 v17, s38, v9
    v_xor_b32 v18, s39, v10
    v_xor_b32 v19, s57, v11
    v_or3_b32 v1, v1, v16, v17
    v_or3_b32 v1, v1, v18, v19
    v_and_b32 v1, 0xff, v1
    v_cmp_ne_u32 vcc, 0, v1
    s_cbranch_vccz Lqd25
    s_sub_u32 s42, s42, 1
    s_cmp_gt_u32 s42, 19936
    s_cbranch_scc1 Lqg24
    ds_write_b32 v57, v59 offset:62108
Lqg24s:
    buffer_wbl2 sc1
    buffer_inv sc1
    s_waitcnt vmcnt(0)
    buffer_load_dwordx4 v[4:7], v40, s[32:35], s47 offen sc1
    buffer_load_dwordx4 v[8:11], v40, s[32:35], s47 offen offset:2048 sc1
    s_waitcnt vmcnt(1)
    v_xor_b32 v12, s37, v4
    v_xor_b32 v13, s38, v5
    v_xor_b32 v14, s39, v6
    v_xor_b32 v15, s57, v7
    v_and_b32 v15, -16, v15
    v_or3_b32 v1, v12, v13, v14
    v_or_b32 v1, v1, v15
    s_waitcnt vmcnt(0)
    v_xor_b32 v16, s37, v8
    v_xor_b32 v17, s38, v9
    v_xor_b32 v18, s39, v10
    v_xor_b32 v19, s57, v11
    v_and_b32 v19, -16, v19
    v_or3_b32 v1, v1, v16, v17
    v_or3_b32 v1, v1, v18, v19
    v_and_b32 v1, 0xff, v1
    v_cmp_ne_u32 vcc, 0, v1
    s_cbranch_vccz Lqd25
    s_sub_u32 s42, s42, 1
    s_cmp_lg_u32 s42, 0
    s_cbranch_scc1 Lqg24s
Lqd25:
    v_add_f32 v12, v12, v16
    v_add_f32 v13, v13, v17
    v_add_f32 v14, v14, v18
    v_add_f32 v15, v15, v19
    s_nop 0
    v_permlane32_swap_b32 v12, v14
    v_permlane32_swap_b32 v13, v15
    v_add_f32 v12, v12, v14
    v_add_f32 v13, v13, v15
    v_cvt_pk_bf16_f32 v12, v12, v13
    ds_write_b32 v41, v12 offset:57344
    s_mov_b64 exec, 1
    ds_add_u32 v57, v59 offset:62080
    s_mov_b64 exec, -1
Lwl28:
    ds_read_b32 v1, v57 offset:62080
    ds_read_b128 v[96:99], v42 offset:57344
    ds_read_b128 v[100:103], v42 offset:57408
    ds_read_b128 v[104:107], v42 offset:57472
    ds_read_b128 v[108:111], v42 offset:57536
    s_waitcnt lgkmcnt(0)
    v_cmp_gt_i32 vcc, 4, v1
    s_cbranch_vccnz Lwl28
    v_mfma_f32_16x16x32_bf16 v[28:31], v[64:67], v[96:99], 0
    v_mfma_f32_16x16x32_bf16 v[32:35], v[80:83], v[96:99], 0
    v_mfma_f32_16x16x32_bf16 v[28:31], v[68:71], v[100:103], v[28:31]
    v_mfma_f32_16x16x32_bf16 v[32:35], v[84:87], v[100:103], v[32:35]
    v_mfma_f32_16x16x32_bf16 v[28:31], v[72:75], v[104:107], v[28:31]
    v_mfma_f32_16x16x32_bf16 v[32:35], v[88:91], v[104:107], v[32:35]
    v_mfma_f32_16x16x32_bf16 v[28:31], v[76:79], v[108:111], v[28:31]
    v_mfma_f32_16x16x32_bf16 v[32:35], v[92:95], v[108:111], v[32:35]
    s_nop 6
    v_cvt_pk_bf16_f32 v4, v28, v29
    v_lshlrev_b32 v28, 16, v4
    v_and_b32 v29, 0xffff0000, v4
    v_mul_f32 v28, 0x3db504f3, v28
    v_mul_f32 v29, 0x3db504f3, v29
    v_cvt_pk_bf16_f32 v4, v28, v29
    v_lshlrev_b32 v28, 16, v4
    v_and_b32 v29, 0xffff0000, v4
    v_cvt_pk_bf16_f32 v4, v30, v31
    v_lshlrev_b32 v30, 16, v4
    v_and_b32 v31, 0xffff0000, v4
    v_mul_f32 v30, 0x3db504f3, v30
    v_mul_f32 v31, 0x3db504f3, v31
    v_cvt_pk_bf16_f32 v4, v30, v31
    v_lshlrev_b32 v30, 16, v4
    v_and_b32 v31, 0xffff0000, v4
    v_cvt_pk_bf16_f32 v4, v32, v33
    v_lshlrev_b32 v32, 16, v4
    v_and_b32 v33, 0xffff0000, v4
    v_mul_f32 v32, 0x3db504f3, v32
    v_mul_f32 v33, 0x3db504f3, v33
    v_cvt_pk_bf16_f32 v4, v32, v33
    v_lshlrev_b32 v32, 16, v4
    v_and_b32 v33, 0xffff0000, v4
    v_cvt_pk_bf16_f32 v4, v34, v35
    v_lshlrev_b32 v34, 16, v4
    v_and_b32 v35, 0xffff0000, v4
    v_mul_f32 v34, 0x3db504f3, v34
    v_mul_f32 v35, 0x3db504f3, v35
    v_cvt_pk_bf16_f32 v4, v34, v35
    v_lshlrev_b32 v34, 16, v4
    v_and_b32 v35, 0xffff0000, v4
    s_mov_b32 s56, 0x3fb8aa3b
    v_max3_f32 v4, v28, v29, v30
    v_max3_f32 v5, v31, v32, v33
    v_max3_f32 v4, v4, v34, v35
    v_max_f32 v4, v4, v5
    v_mov_b32 v5, v4
    s_nop 1
    v_permlane32_swap_b32 v4, v5
    v_max_f32 v4, v4, v5
    v_mov_b32 v5, v4
    s_nop 1
    v_permlane16_swap_b32 v4, v5
    v_max_f32 v4, v4, v5
    s_mov_b64 exec, 15
    ds_write_b32 v47, v4 offset:61952
    s_mov_b64 exec, 1
    ds_add_u32 v57, v59 offset:62084
    s_mov_b64 exec, -1
Lwl29:
    ds_read_b32 v1, v57 offset:62084
    ds_read_b128 v[4:7], v46 offset:61952
    s_waitcnt lgkmcnt(0)
    v_cmp_gt_i32 vcc, 4, v1
    s_cbranch_vccnz Lwl29
    v_max3_f32 v4, v4, v5, v6
    v_max_f32 v4, v4, v7
    v_mul_f32 v36, s56, v4
    v_fma_f32 v28, v28, s56, -v36
    v_fma_f32 v29, v29, s56, -v36
    v_fma_f32 v30, v30, s56, -v36
    v_fma_f32 v31, v31, s56, -v36
    v_fma_f32 v32, v32, s56, -v36
    v_fma_f32 v33, v33, s56, -v36
    v_fma_f32 v34, v34, s56, -v36
    v_fma_f32 v35, v35, s56, -v36
    v_exp_f32 v28, v28
    v_exp_f32 v29, v29
    v_exp_f32 v30, v30
    v_exp_f32 v31, v31
    v_exp_f32 v32, v32
    v_exp_f32 v33, v33
    v_exp_f32 v34, v34
    v_exp_f32 v35, v35
    v_cvt_pk_bf16_f32 v4, v28, v29
    v_cvt_pk_bf16_f32 v5, v30, v31
    v_cvt_pk_bf16_f32 v6, v32, v33
    v_cvt_pk_bf16_f32 v7, v34, v35
    s_mov_b64 exec, s[52:53]
    ds_write_b64 v43, v[4:5] offset:58624
    ds_write_b64 v43, v[6:7] offset:58656
    s_mov_b64 exec, -1
    v_add_f32 v28, v28, v29
    v_add_f32 v30, v30, v31
    v_add_f32 v32, v32, v33
    v_add_f32 v34, v34, v35
    v_add_f32 v28, v28, v30
    v_add_f32 v32, v32, v34
    v_add_f32 v28, v28, v32
    v_mov_b32 v29, v28
    s_nop 1
    v_permlane32_swap_b32 v28, v29
    v_add_f32 v28, v28, v29
    v_mov_b32 v29, v28
    s_nop 1
    v_permlane16_swap_b32 v28, v29
    v_add_f32 v28, v28, v29
    s_mov_b64 exec, 15
    ds_write_b32 v47, v28 offset:62016
    s_mov_b64 exec, 1
    ds_add_u32 v57, v59 offset:62088
    s_mov_b64 exec, -1
Lwl30:
    ds_read_b32 v1, v57 offset:62088
    ds_read_b128 v[4:7], v46 offset:62016
    ds_read_b128 v[96:99], v42 offset:58624
    ds_read_b128 v[100:103], v42 offset:58688
    ds_read_b128 v[104:107], v42 offset:58752
    ds_read_b128 v[108:111], v42 offset:58816
    s_waitcnt lgkmcnt(0)
    v_cmp_gt_i32 vcc, 4, v1
    s_cbranch_vccnz Lwl30
    v_add_f32 v4, v4, v5
    v_add_f32 v6, v6, v7
    v_add_f32 v37, v4, v6
    v_mov_b32 v38, s36
    v_mov_b32 v39, s36
    s_mov_b64 exec, s[58:59]
    buffer_store_dwordx4 v[36:39], v57, s[32:35], s48 offen
    s_mov_b64 exec, -1
Lwl31:
    ds_read_b32 v1, v57 offset:62208
    s_waitcnt lgkmcnt(0)
    v_cmp_gt_i32 vcc, 83, v1
    s_cbranch_vccnz Lwl31
Lwl32:
    ds_read_b32 v1, v57 offset:62208
    ds_read_b64_tr_b16 v[64:65], v52 offset:0
    ds_read_b64_tr_b16 v[66:67], v52 offset:1024
    ds_read_b64_tr_b16 v[68:69], v52 offset:8192
    ds_read_b64_tr_b16 v[70:71], v52 offset:9216
    ds_read_b64_tr_b16 v[72:73], v52 offset:16384
    ds_read_b64_tr_b16 v[74:75], v52 offset:17408
    ds_read_b64_tr_b16 v[76:77], v52 offset:24576
    ds_read_b64_tr_b16 v[78:79], v52 offset:25600
    s_waitcnt lgkmcnt(0)
    v_cmp_gt_i32 vcc, 85, v1
    s_cbranch_vccnz Lwl32
    ds_read_b64_tr_b16 v[80:81], v53 offset:0
    ds_read_b64_tr_b16 v[82:83], v53 offset:1024
    ds_read_b64_tr_b16 v[84:85], v53 offset:8192
    ds_read_b64_tr_b16 v[86:87], v53 offset:9216
    ds_read_b64_tr_b16 v[88:89], v53 offset:16384
    ds_read_b64_tr_b16 v[90:91], v53 offset:17408
    ds_read_b64_tr_b16 v[92:93], v53 offset:24576
    ds_read_b64_tr_b16 v[94:95], v53 offset:25600
    v_mfma_f32_16x16x32_bf16 v[28:31], v[64:67], v[96:99], 0
    v_mfma_f32_16x16x32_bf16 v[28:31], v[68:71], v[100:103], v[28:31]
    v_mfma_f32_16x16x32_bf16 v[28:31], v[72:75], v[104:107], v[28:31]
    v_mfma_f32_16x16x32_bf16 v[28:31], v[76:79], v[108:111], v[28:31]
    s_waitcnt lgkmcnt(0)
    v_mfma_f32_16x16x32_bf16 v[32:35], v[80:83], v[96:99], 0
    v_mfma_f32_16x16x32_bf16 v[32:35], v[84:87], v[100:103], v[32:35]
    v_mfma_f32_16x16x32_bf16 v[32:35], v[88:91], v[104:107], v[32:35]
    v_mfma_f32_16x16x32_bf16 v[32:35], v[92:95], v[108:111], v[32:35]
    s_nop 2
    v_and_or_b32 v28, v28, s41, v60
    v_and_or_b32 v29, v29, s41, v61
    v_and_or_b32 v30, v30, s41, v62
    v_and_or_b32 v31, v31, s41, v63
    s_mov_b64 exec, s[52:53]
    buffer_store_dwordx4 v[28:31], v44, s[32:35], s49 offen
    v_and_or_b32 v32, v32, s41, v60
    v_and_or_b32 v33, v33, s41, v61
    v_and_or_b32 v34, v34, s41, v62
    v_and_or_b32 v35, v35, s41, v63
    buffer_store_dwordx4 v[32:35], v44, s[32:35], s49 offen offset:64
    s_mov_b64 exec, -1
Lwl33:
    ds_read_b32 v1, v57 offset:62208
    s_waitcnt lgkmcnt(0)
    v_cmp_gt_i32 vcc, 115, v1
    s_cbranch_vccnz Lwl33
    s_mov_b32 s42, 20000
    buffer_load_dwordx4 v[4:7], v54, s[32:35], s50 offen sc1
    buffer_load_dwordx4 v[64:67], v55, s[32:35], s51 offen sc1
    buffer_load_dwordx4 v[68:71], v55, s[32:35], s51 offen offset:128 sc1
    buffer_load_dwordx4 v[72:75], v55, s[32:35], s51 offen offset:256 sc1
    buffer_load_dwordx4 v[76:79], v55, s[32:35], s51 offen offset:384 sc1
Lwl37:
    ds_read_b32 v1, v57 offset:62208
    s_waitcnt lgkmcnt(0)
    v_cmp_gt_i32 vcc, 116, v1
    s_cbranch_vccnz Lwl37
Lwl38:
    ds_read_b32 v1, v57 offset:62208
    ds_read_b64_tr_b16 v[96:97], v56 offset:32768
    ds_read_b64_tr_b16 v[98:99], v56 offset:33280
    ds_read_b64_tr_b16 v[100:101], v56 offset:36864
    ds_read_b64_tr_b16 v[102:103], v56 offset:37376
    ds_read_b64_tr_b16 v[104:105], v56 offset:40960
    ds_read_b64_tr_b16 v[106:107], v56 offset:41472
    ds_read_b64_tr_b16 v[108:109], v56 offset:45056
    ds_read_b64_tr_b16 v[110:111], v56 offset:45568
    s_waitcnt lgkmcnt(0)
    v_cmp_gt_i32 vcc, 117, v1
    s_cbranch_vccnz Lwl38
    s_branch Loc36
Log34:
    buffer_load_dwordx4 v[4:7], v54, s[32:35], s50 offen sc1
    buffer_load_dwordx4 v[64:67], v55, s[32:35], s51 offen sc1
    buffer_load_dwordx4 v[68:71], v55, s[32:35], s51 offen offset:128 sc1
    buffer_load_dwordx4 v[72:75], v55, s[32:35], s51 offen offset:256 sc1
    buffer_load_dwordx4 v[76:79], v55, s[32:35], s51 offen offset:384 sc1
Loc36:
    s_waitcnt vmcnt(4)
    v_xor_b32 v1, s36, v6
    v_max_f32 v6, v4, v4 row_ror:8
    v_cmp_ne_u32 s[60:61], 0, v1
    v_mov_b32 v7, v6
    s_nop 1
    v_permlane32_swap_b32 v6, v7
    v_max_f32 v6, v6, v7
    v_mov_b32 v7, v6
    s_nop 1
    v_permlane16_swap_b32 v6, v7
    v_max_f32 v6, v6, v7
    v_sub_f32 v6, v4, v6
    v_exp_f32 v36, v6
    s_waitcnt vmcnt(3)
    v_xor_b32 v80, s37, v64
    v_xor_b32 v81, s38, v65
    v_xor_b32 v82, s39, v66
    v_xor_b32 v83, s40, v67
    v_or3_b32 v1, v80, v81, v82
    v_or_b32 v1, v1, v83
    s_waitcnt vmcnt(2)
    v_xor_b32 v84, s37, v68
    v_xor_b32 v85, s38, v69
    v_xor_b32 v86, s39, v70
    v_xor_b32 v87, s40, v71
    v_or3_b32 v1, v1, v84, v85
    v_or3_b32 v1, v1, v86, v87
    s_waitcnt vmcnt(1)
    v_xor_b32 v88, s37, v72
    v_xor_b32 v89, s38, v73
    v_xor_b32 v90, s39, v74
    v_xor_b32 v91, s40, v75
    v_or3_b32 v1, v1, v88, v89
    v_or3_b32 v1, v1, v90, v91
    s_waitcnt vmcnt(0)
    v_xor_b32 v92, s37, v76
    v_xor_b32 v93, s38, v77
    v_xor_b32 v94, s39, v78
    v_xor_b32 v95, s40, v79
    v_or3_b32 v1, v1, v92, v93
    v_or3_b32 v1, v1, v94, v95
    v_and_b32 v1, 0xff, v1
    v_cmp_ne_u32 vcc, 0, v1
    s_nop 0
    s_or_b64 vcc, vcc, s[60:61]
    s_cbranch_vccz Lod35
    s_sub_u32 s42, s42, 1
    s_cmp_gt_u32 s42, 19936
    s_cbranch_scc1 Log34
    buffer_wbl2 sc1
    buffer_inv sc1
    s_waitcnt vmcnt(0)
    s_cmp_lg_u32 s42, 0
    s_cbranch_scc1 Log34
Lod35:
    v_mul_f32 v5, v5, v36
    v_pk_mul_f32 v[80:81], v[80:81], v[36:37] op_sel_hi:[1,0]
    v_pk_mul_f32 v[82:83], v[82:83], v[36:37] op_sel_hi:[1,0]
    v_pk_mul_f32 v[84:85], v[84:85], v[36:37] op_sel_hi:[1,0]
    v_pk_mul_f32 v[86:87], v[86:87], v[36:37] op_sel_hi:[1,0]
    v_add_f32 v5, v5, v5 row_ror:8
    v_pk_mul_f32 v[88:89], v[88:89], v[36:37] op_sel_hi:[1,0]
    v_pk_mul_f32 v[90:91], v[90:91], v[36:37] op_sel_hi:[1,0]
    v_pk_mul_f32 v[92:93], v[92:93], v[36:37] op_sel_hi:[1,0]
    v_pk_mul_f32 v[94:95], v[94:95], v[36:37] op_sel_hi:[1,0]
    v_mov_b32 v7, v5
    v_permlane32_swap_b32 v80, v88
    v_permlane32_swap_b32 v81, v89
    v_permlane32_swap_b32 v82, v90
    v_permlane32_swap_b32 v83, v91
    v_permlane32_swap_b32 v84, v92
    v_permlane32_swap_b32 v85, v93
    v_permlane32_swap_b32 v86, v94
    v_permlane32_swap_b32 v87, v95
    v_permlane32_swap_b32 v5, v7
    v_pk_add_f32 v[80:81], v[80:81], v[88:89]
    v_pk_add_f32 v[82:83], v[82:83], v[90:91]
    v_pk_add_f32 v[84:85], v[84:85], v[92:93]
    v_pk_add_f32 v[86:87], v[86:87], v[94:95]
    v_add_f32 v5, v5, v7
    v_mov_b32 v7, v5
    v_permlane16_swap_b32 v80, v84
    v_permlane16_swap_b32 v81, v85
    v_permlane16_swap_b32 v82, v86
    v_permlane16_swap_b32 v83, v87
    v_permlane16_swap_b32 v5, v7
    v_pk_add_f32 v[80:81], v[80:81], v[84:85]
    v_pk_add_f32 v[82:83], v[82:83], v[86:87]
    v_add_f32 v6, v5, v7
    v_rcp_f32 v6, v6
    v_add_f32 v80, v80, v80 row_ror:8
    v_add_f32 v81, v81, v81 row_ror:8
    v_add_f32 v82, v82, v82 row_ror:8
    v_add_f32 v83, v83, v83 row_ror:8
    v_pk_mul_f32 v[80:81], v[80:81], v[6:7] op_sel_hi:[1,0]
    v_pk_mul_f32 v[82:83], v[82:83], v[6:7] op_sel_hi:[1,0]
    v_cvt_pk_bf16_f32 v80, v80, v81
    v_cvt_pk_bf16_f32 v81, v82, v83
    ds_write_b64 v58, v[80:81] offset:59904
    s_mov_b64 exec, 1
    ds_add_u32 v57, v59 offset:62092
    s_mov_b64 exec, -1
Lwl39:
    ds_read_b32 v1, v57 offset:62092
    ds_read_b128 v[64:67], v42 offset:59904
    ds_read_b128 v[68:71], v42 offset:59968
    ds_read_b128 v[72:75], v42 offset:60032
    ds_read_b128 v[76:79], v42 offset:60096
    s_waitcnt lgkmcnt(0)
    v_cmp_gt_i32 vcc, 4, v1
    s_cbranch_vccnz Lwl39
    v_mfma_f32_16x16x32_bf16 v[28:31], v[64:67], v[96:99], 0
    v_mfma_f32_16x16x32_bf16 v[28:31], v[68:71], v[100:103], v[28:31]
    v_mfma_f32_16x16x32_bf16 v[28:31], v[72:75], v[104:107], v[28:31]
    v_mfma_f32_16x16x32_bf16 v[28:31], v[76:79], v[108:111], v[28:31]
    s_nop 7
    v_and_or_b32 v28, v28, s41, v60
    v_and_or_b32 v29, v29, s41, v61
    v_and_or_b32 v30, v30, s41, v62
    v_and_or_b32 v31, v31, s41, v63
    s_mov_b64 exec, 0xffff
    buffer_store_dwordx4 v[28:31], v45, s[32:35], s54 offen sc1
    s_waitcnt vmcnt(0)
    s_mov_b64 exec, 1
    ds_add_u32 v57, v59 offset:62104
    s_mov_b64 exec, -1
    s_endpgm
L_last:
    s_endpgm
.section .rodata,"a"
.p2align 6
.amdhsa_kernel recurrent_scan__sliding_block_cached__glu_gated_swiglu__decode_kernel
  .amdhsa_next_free_vgpr 120
  .amdhsa_next_free_sgpr 102
  .amdhsa_accum_offset 120
  .amdhsa_group_segment_fixed_size 0
  .amdhsa_kernarg_size 96
  .amdhsa_user_sgpr_count 2
  .amdhsa_user_sgpr_kernarg_segment_ptr 1
  .amdhsa_system_sgpr_workgroup_id_x 1
.end_amdhsa_kernel
```
